```python
import torch

def _softmax(x, axis=-1):
    return torch.softmax(x, dim=axis)
def _gelu(x):
    return torch.nn.functional.gelu(x, approximate="tanh")
def _silu(x):
    return torch.nn.functional.silu(x)
def _sigmoid(x):
    return torch.sigmoid(x)
def _layernorm(x, axis=-1, eps=1e-5):
    m = x.mean(dim=axis, keepdim=True)
    v = x.var(dim=axis, keepdim=True, unbiased=False)
    return (x - m) / torch.sqrt(v + eps)
def _scatter_add(tgt, idx, src, axis=0):
    return tgt.clone().index_add_(axis, idx, src)
def _segment_sum(src, seg, n):
    out = torch.zeros((n,) + src.shape[1:], dtype=src.dtype)
    return out.index_add_(0, seg, src)
def _pad(x, pw):
    flat = tuple(v for pair in reversed(pw) for v in pair)
    return torch.nn.functional.pad(x, flat)

kernel_name = 'standalone__instancenorm__prompt'

def setup_inputs():

    _w = (lambda a: (lambda t: t.to(torch.bfloat16) if t.is_floating_point() else t)(torch.as_tensor(a)))
    B, C, H, W = 1, 576, 2048, 32
    return {
        "x": _w(abs((lambda *s: torch.randn(*s, dtype=torch.bfloat16) * 0.05)(B, C, H, W))),
        "g": _w((lambda *s: torch.randn(*s, dtype=torch.bfloat16) * 0.05)(C) + 1.0),
        "b": _w((lambda *s: torch.randn(*s, dtype=torch.bfloat16) * 0.4)(C)),
    }

def reference(x, g, b):
    mu = x.mean(axis=(-2, -1), keepdims=True)
    var = ((x - mu) ** 2).mean(axis=(-2, -1), keepdims=True)
    xhat = (x - mu) / torch.sqrt(var + 1e-5)
    return xhat * g.reshape(1, -1, 1, 1) + b.reshape(1, -1, 1, 1)
```

```asm
; @launch grid=(256,1,1) block=(832,1,1) lds=6400
.amdgcn_target "amdgcn-amd-amdhsa--gfx950"
.text
.globl standalone__instancenorm__prompt_kernel
.p2align 8
.type standalone__instancenorm__prompt_kernel,@function
standalone__instancenorm__prompt_kernel:
    s_load_dwordx4 s[4:7], s[0:1], 0
    s_load_dwordx4 s[8:11], s[0:1], 16
    s_load_dwordx4 s[20:23], s[0:1], 32
    s_cmp_ge_u32 s2, 256
    s_cbranch_scc1 L_done
    v_lshrrev_b32 v2, 6, v0
    v_and_b32 v3, 63, v0
    v_readfirstlane_b32 s24, v2
    s_lshr_b32 s25, s2, 6
    s_lshl_b32 s25, s25, 3
    s_and_b32 s26, s2, 7
    s_or_b32 s25, s25, s26
    s_bfe_u32 s27, s2, 0x30003
    s_lshl_b32 s25, s25, 3
    s_or_b32 s25, s25, s27
    s_sub_u32 s24, s24, 1
    s_cmp_ge_u32 s24, 8
    s_cbranch_scc1 L_helper
    s_lshl_b32 s40, s25, 14
    s_lshl_b32 s29, s24, 10
    v_lshl_add_u32 v1, v3, 4, s29
    s_add_u32 s41, s40, 0x2000
    s_mov_b32 s14, 75497472
    s_mov_b32 s15, 0x20000
    s_waitcnt lgkmcnt(0)
    s_mov_b32 s12, s4
    s_mov_b32 s13, s5
    buffer_load_dwordx4 v[16:19], v1, s[12:15], s40 offen nt
    buffer_load_dwordx4 v[20:23], v1, s[12:15], s41 offen nt
    s_branch L_data
L_helper:
    s_setprio 3
    s_cmp_lt_i32 s24, 0
    s_cbranch_scc0 L_xwave
    s_getpc_b64 s[44:45]
L_pc:
    v_lshlrev_b32 v11, 7, v3
    v_min_u32 v11, L_codeend-L_pc-4, v11
    global_load_dword v30, v11, s[44:45]
    s_lshr_b32 s33, s2, 3
    s_sub_u32 s33, s33, 1
    s_sub_u32 s15, s33, 12
    s_cmp_lt_u32 s15, 12
    s_cselect_b32 s33, s15, s33
    s_cselect_b32 s15, 8, 0
    s_add_u32 s26, s26, s15
    s_lshr_b32 s14, s33, 1
    s_lshl_b32 s14, s14, 23
    s_mul_i32 s15, s26, 0x180
    s_add_u32 s14, s14, s15
    s_add_u32 s14, s14, 0x19f0000
    s_mov_b32 s3, 1703936
    s_bitcmp1_b32 s33, 0
    s_waitcnt lgkmcnt(0)
    s_cselect_b32 s12, s10, s4
    s_cselect_b32 s13, s11, s5
    s_xor_b32 s32, s4, s10
    s_and_b32 s32, s32, 0x1fff
    s_cselect_b32 s32, 0xaaa, 0
    s_bitcmp1_b32 s32, s33
    s_cselect_b32 s33, -1, s33
    s_cmp_lt_u32 s33, 12
    s_cbranch_scc0 L_notouch
    s_load_dword s18, s[12:13], s14 glc
L_notouch:
    s_cmp_lt_u32 s2, 8
    s_cbranch_scc0 L_nozero
    s_lshl_b32 s44, s2, 8
    s_add_u32 s44, s44, 1720320
    s_add_u32 s44, s44, s22
    s_addc_u32 s45, s23, 0
    s_mov_b64 s[52:53], 0
    s_atomic_swap s52, s[44:45], 0 glc
    s_atomic_swap s53, s[44:45], 128 glc
L_nozero:
    s_load_dword s36, s[22:23], s3
    s_mov_b64 exec, 0xff
    v_mov_b32 v9, 0
    s_getreg_b32 s41, hwreg(HW_REG_XCC_ID)
    s_and_b32 s41, s41, 7
    s_barrier
    s_waitcnt lgkmcnt(0)
    s_add_u32 s36, s36, 1
    v_mov_b32 v4, s36
    ds_write_b32 v9, v4 offset:1408
    ds_write_b32 v9, v9 offset:1412
    s_and_b32 s44, s2, 3
    s_lshl_b32 s45, 0x1000, s44
    s_lshl_b32 s44, s44, 6
    s_lshl_b32 s3, s2, 2
    s_and_b32 s3, s3, 16
    s_lshl_b32 s45, s45, s3
    s_cmp_lt_u32 s2, 8
    s_cbranch_scc1 L_send
    s_cmp_lt_u32 s33, 12
    s_cbranch_scc0 L_noprobe
L_prb:
    s_memrealtime s[48:49]
    s_waitcnt lgkmcnt(0)
    s_load_dword s18, s[12:13], s14 glc
    s_waitcnt lgkmcnt(0)
    s_memrealtime s[50:51]
    s_waitcnt lgkmcnt(0)
    s_sub_u32 s48, s50, s48
    s_cmp_lt_u32 s48, 21
    s_cbranch_scc1 L_report
    ds_read_b32 v4, v9 offset:1552
    s_waitcnt lgkmcnt(0)
    v_readfirstlane_b32 s3, v4
    s_cmp_eq_u32 s3, -1
    s_cbranch_scc1 L_prb
    s_branch L_noprobe
L_report:
    s_lshl_b32 s45, s41, 2
    s_and_b32 s45, s45, 16
    s_add_u32 s45, s45, s33
    s_lshl_b32 s45, 1, s45
L_send:
    s_atomic_or s45, s[20:21], s44
L_noprobe:
    s_branch L_claimer
L_xwave:
    v_mov_b32 v4, -1
    v_mov_b32 v5, -1
    v_mov_b32 v6, -1
    v_mov_b32 v7, -1
    v_subrev_u32 v9, 576, v0
    v_lshlrev_b32 v9, 4, v9
    ds_write_b128 v9, v[4:7] offset:0
    v_cmp_gt_u32 vcc, 2064, v9
    s_and_saveexec_b64 s[40:41], vcc
    ds_write_b128 v9, v[4:7] offset:4096
    s_cmp_lg_u32 s24, 8
    s_cbranch_scc1 L_xbar
    s_mov_b64 exec, 127
    s_lshl_b32 s3, s25, 14
    v_lshl_add_u32 v4, v3, 22, s3
    v_add_u32 v5, 0x2000, v4
    v_lshl_add_u32 v6, v3, 8, s25
    v_lshlrev_b32 v7, 5, v3
    ds_write_b64 v7, v[4:5] offset:0
    ds_write_b32 v7, v6 offset:16
L_xbar:
    s_mov_b64 exec, 0xff
    v_lshlrev_b32 v8, 3, v3
    s_waitcnt lgkmcnt(0)
    v_mov_b32 v9, 0
    s_barrier
    s_branch L_tagw
L_data:
    v_lshrrev_b32 v2, 3, v3
    v_and_b32 v2, 4, v2
    s_lshl_b32 s3, s24, 4
    v_add_u32 v2, s3, v2
    s_add_u32 s3, s3, 8
    v_writelane_b32 v2, s3, 0
    v_and_b32 v0, 7, v3
    v_lshlrev_b32 v0, 4, v0
    v_mov_b32 v3, 0
    v_mov_b32 v32, 0
    s_mov_b32 s37, 0xffff0000
    s_mov_b32 s38, 0x00010001
    s_mov_b32 s39, 0x00010000
    s_mov_b32 s16, s10
    s_mov_b32 s17, s11
    s_mov_b32 s18, 75497472
    s_mov_b32 s19, 0x20000
    s_mov_b32 s44, 0
    s_mov_b32 s45, 0
    s_mov_b32 s46, 0x7
    s_mov_b32 s47, 0x7ff00000
    s_mov_b32 s51, 0
    s_add_u32 s42, s40, 4194304
    s_add_u32 s43, s41, 4194304
    s_barrier
    buffer_store_dwordx4 v[36:39], v1, s[16:19], s47 offen
    buffer_store_dwordx4 v[36:39], v1, s[16:19], s47 offen
    buffer_load_dwordx4 v[24:27], v1, s[12:15], s42 offen nt
    buffer_load_dwordx4 v[28:31], v1, s[12:15], s43 offen nt
    buffer_store_dwordx4 v[36:39], v1, s[16:19], s47 offen
    buffer_store_dwordx4 v[36:39], v1, s[16:19], s47 offen
L_loop:
    s_cmp_lt_i32 s40, 0
    s_cbranch_scc1 L_void0
    s_waitcnt vmcnt(7)
    v_readfirstlane_b32 s35, v16
    v_lshlrev_b32 v8, 16, v16
    v_and_b32 v9, s37, v16
    v_lshlrev_b32 v10, 16, v17
    v_and_b32 v11, s37, v17
    v_lshlrev_b32 v12, 16, v18
    v_and_b32 v13, s37, v18
    v_lshlrev_b32 v14, 16, v19
    v_and_b32 v15, s37, v19
    s_lshl_b32 s35, s35, 16
    s_xor_b32 s34, s35, 0x80000000
    v_pk_add_f32 v[8:9], v[8:9], s[34:35] op_sel_hi:[1,0]
    v_pk_add_f32 v[10:11], v[10:11], s[34:35] op_sel_hi:[1,0]
    v_pk_add_f32 v[12:13], v[12:13], s[34:35] op_sel_hi:[1,0]
    v_pk_add_f32 v[14:15], v[14:15], s[34:35] op_sel_hi:[1,0]
    v_pk_mul_f32 v[6:7], v[8:9], v[8:9]
    v_pk_add_f32 v[4:5], v[8:9], v[10:11]
    v_pk_fma_f32 v[6:7], v[10:11], v[10:11], v[6:7]
    v_pk_add_f32 v[4:5], v[4:5], v[12:13]
    v_pk_fma_f32 v[6:7], v[12:13], v[12:13], v[6:7]
    v_pk_add_f32 v[4:5], v[4:5], v[14:15]
    v_pk_fma_f32 v[6:7], v[14:15], v[14:15], v[6:7]
    s_waitcnt vmcnt(6)
    v_lshlrev_b32 v8, 16, v20
    v_and_b32 v9, s37, v20
    v_lshlrev_b32 v10, 16, v21
    v_and_b32 v11, s37, v21
    v_lshlrev_b32 v12, 16, v22
    v_and_b32 v13, s37, v22
    v_lshlrev_b32 v14, 16, v23
    v_and_b32 v15, s37, v23
    v_pk_add_f32 v[8:9], v[8:9], s[34:35] op_sel_hi:[1,0]
    v_pk_add_f32 v[10:11], v[10:11], s[34:35] op_sel_hi:[1,0]
    v_pk_add_f32 v[12:13], v[12:13], s[34:35] op_sel_hi:[1,0]
    v_pk_add_f32 v[14:15], v[14:15], s[34:35] op_sel_hi:[1,0]
    v_pk_add_f32 v[4:5], v[4:5], v[8:9]
    v_pk_fma_f32 v[6:7], v[8:9], v[8:9], v[6:7]
    v_pk_add_f32 v[4:5], v[4:5], v[10:11]
    v_pk_fma_f32 v[6:7], v[10:11], v[10:11], v[6:7]
    v_pk_add_f32 v[4:5], v[4:5], v[12:13]
    v_pk_fma_f32 v[6:7], v[12:13], v[12:13], v[6:7]
    v_pk_add_f32 v[4:5], v[4:5], v[14:15]
    v_pk_fma_f32 v[6:7], v[14:15], v[14:15], v[6:7]
    v_add_f32 v4, v4, v5
    v_add_f32 v6, v6, v7
    s_nop 1
    v_permlane32_swap_b32 v4, v6
    s_nop 1
    v_add_f32 v4, v4, v6
    s_nop 1
    v_add_f32_dpp v4, v4, v4 quad_perm:[1,0,3,2] row_mask:0xf bank_mask:0xf
    s_nop 1
    v_add_f32_dpp v4, v4, v4 quad_perm:[2,3,0,1] row_mask:0xf bank_mask:0xf
    s_nop 1
    v_add_f32_dpp v4, v4, v4 row_half_mirror row_mask:0xf bank_mask:0xf
    s_nop 1
    v_add_f32_dpp v4, v4, v4 row_mirror row_mask:0xf bank_mask:0xf
    s_nop 1
    v_add_f32_dpp v4, v4, v4 row_bcast:15 row_mask:0xa bank_mask:0xf
    v_writelane_b32 v4, s35, 0
    s_mov_b64 exec, s[38:39]
    ds_write_b32 v2, v4 offset:1424
    s_mov_b64 exec, -1
    s_set_gpr_idx_on s44, gpr_idx(DST)
    s_nop 0
    v_mov_b64 v[40:41], v[16:17]
    v_mov_b64 v[42:43], v[18:19]
    v_mov_b64 v[44:45], v[20:21]
    v_mov_b64 v[46:47], v[22:23]
    s_set_gpr_idx_off
    s_add_u32 s51, s51, 1
    s_add_u32 s44, s44, 8
    s_cmp_lt_u32 s44, 80
    s_cselect_b32 s44, s44, 0
L_sync0:
    ds_read_b32 v6, v0 offset:1424
    ds_read_b64 v[4:5], v32 offset:64
    s_waitcnt lgkmcnt(0)
    v_cmp_eq_u32 vcc, -1, v6
    v_readfirstlane_b32 s40, v4
    v_readfirstlane_b32 s41, v5
    s_cmp_eq_u64 vcc, 0
    s_cbranch_scc0 L_sync0
    s_cmp_eq_u32 s40, -1
    s_cbranch_scc1 L_sync0
    s_cmp_lt_u32 s51, 7
    s_cselect_b32 s3, 3, 1
    s_and_b32 s3, s3, s41
    s_and_b32 s33, s46, 1
    s_or_b32 s3, s3, s33
    s_and_b32 s41, s41, -4
    s_cmp_lt_u32 s51, 10
    s_cselect_b32 s3, s3, 0
    buffer_load_dwordx4 v[16:19], v1, s[12:15], s40 offen nt
    buffer_load_dwordx4 v[20:23], v1, s[12:15], s41 offen nt
    s_lshr_b32 s46, s46, 1
    s_cmp_eq_u32 s3, 0
    s_cbranch_scc1 L_store0
    buffer_store_dwordx4 v[36:39], v1, s[16:19], s47 offen
    buffer_store_dwordx4 v[36:39], v1, s[16:19], s47 offen
    s_branch L_next0
L_void0:
L_store0:
    ds_read_b128 v[4:7], v3 offset:0
    s_waitcnt lgkmcnt(0)
    v_readfirstlane_b32 s48, v4
    v_readfirstlane_b32 s49, v5
    v_cmp_eq_u32 vcc, -1, v7
    s_cmp_lt_i32 s48, 0
    s_cbranch_scc1 L_fin
    s_and_b32 s49, s49, -4
    s_cmp_eq_u64 vcc, 0
    s_cbranch_scc1 L_gres0
    s_sleep 1
    s_branch L_store0
L_gres0:
    s_set_gpr_idx_on s45, gpr_idx(SRC1)
    s_nop 0
    v_lshlrev_b32 v8, 16, v40
    v_and_b32 v9, s37, v40
    v_lshlrev_b32 v10, 16, v41
    v_and_b32 v11, s37, v41
    v_lshlrev_b32 v12, 16, v42
    v_and_b32 v13, s37, v42
    v_lshlrev_b32 v14, 16, v43
    v_and_b32 v15, s37, v43
    s_set_gpr_idx_off
    v_pk_fma_f32 v[8:9], v[8:9], v[6:7], v[6:7] op_sel:[0,0,1] op_sel_hi:[1,0,1]
    v_pk_fma_f32 v[10:11], v[10:11], v[6:7], v[6:7] op_sel:[0,0,1] op_sel_hi:[1,0,1]
    v_pk_fma_f32 v[12:13], v[12:13], v[6:7], v[6:7] op_sel:[0,0,1] op_sel_hi:[1,0,1]
    v_pk_fma_f32 v[14:15], v[14:15], v[6:7], v[6:7] op_sel:[0,0,1] op_sel_hi:[1,0,1]
    v_cvt_pk_bf16_f32 v36, v8, v9
    v_cvt_pk_bf16_f32 v37, v10, v11
    v_cvt_pk_bf16_f32 v38, v12, v13
    v_cvt_pk_bf16_f32 v39, v14, v15
    buffer_store_dwordx4 v[36:39], v1, s[16:19], s48 offen sc0 sc1
    s_set_gpr_idx_on s45, gpr_idx(SRC1)
    s_nop 0
    v_lshlrev_b32 v8, 16, v44
    v_and_b32 v9, s37, v44
    v_lshlrev_b32 v10, 16, v45
    v_and_b32 v11, s37, v45
    v_lshlrev_b32 v12, 16, v46
    v_and_b32 v13, s37, v46
    v_lshlrev_b32 v14, 16, v47
    v_and_b32 v15, s37, v47
    s_set_gpr_idx_off
    v_pk_fma_f32 v[8:9], v[8:9], v[6:7], v[6:7] op_sel:[0,0,1] op_sel_hi:[1,0,1]
    v_pk_fma_f32 v[10:11], v[10:11], v[6:7], v[6:7] op_sel:[0,0,1] op_sel_hi:[1,0,1]
    v_pk_fma_f32 v[12:13], v[12:13], v[6:7], v[6:7] op_sel:[0,0,1] op_sel_hi:[1,0,1]
    v_pk_fma_f32 v[14:15], v[14:15], v[6:7], v[6:7] op_sel:[0,0,1] op_sel_hi:[1,0,1]
    v_cvt_pk_bf16_f32 v8, v8, v9
    v_cvt_pk_bf16_f32 v9, v10, v11
    v_cvt_pk_bf16_f32 v10, v12, v13
    v_cvt_pk_bf16_f32 v11, v14, v15
    buffer_store_dwordx4 v[8:11], v1, s[16:19], s49 offen sc0 sc1
    s_add_u32 s45, s45, 8
    s_cmp_lt_u32 s45, 80
    s_cselect_b32 s45, s45, 0
    v_add_u32 v3, 32, v3
    s_sub_u32 s51, s51, 1
L_next0:
    s_cmp_lt_i32 s42, 0
    s_cbranch_scc1 L_void1
    s_waitcnt vmcnt(7)
    v_readfirstlane_b32 s35, v24
    v_lshlrev_b32 v8, 16, v24
    v_and_b32 v9, s37, v24
    v_lshlrev_b32 v10, 16, v25
    v_and_b32 v11, s37, v25
    v_lshlrev_b32 v12, 16, v26
    v_and_b32 v13, s37, v26
    v_lshlrev_b32 v14, 16, v27
    v_and_b32 v15, s37, v27
    s_lshl_b32 s35, s35, 16
    s_xor_b32 s34, s35, 0x80000000
    v_pk_add_f32 v[8:9], v[8:9], s[34:35] op_sel_hi:[1,0]
    v_pk_add_f32 v[10:11], v[10:11], s[34:35] op_sel_hi:[1,0]
    v_pk_add_f32 v[12:13], v[12:13], s[34:35] op_sel_hi:[1,0]
    v_pk_add_f32 v[14:15], v[14:15], s[34:35] op_sel_hi:[1,0]
    v_pk_mul_f32 v[6:7], v[8:9], v[8:9]
    v_pk_add_f32 v[4:5], v[8:9], v[10:11]
    v_pk_fma_f32 v[6:7], v[10:11], v[10:11], v[6:7]
    v_pk_add_f32 v[4:5], v[4:5], v[12:13]
    v_pk_fma_f32 v[6:7], v[12:13], v[12:13], v[6:7]
    v_pk_add_f32 v[4:5], v[4:5], v[14:15]
    v_pk_fma_f32 v[6:7], v[14:15], v[14:15], v[6:7]
    s_waitcnt vmcnt(6)
    v_lshlrev_b32 v8, 16, v28
    v_and_b32 v9, s37, v28
    v_lshlrev_b32 v10, 16, v29
    v_and_b32 v11, s37, v29
    v_lshlrev_b32 v12, 16, v30
    v_and_b32 v13, s37, v30
    v_lshlrev_b32 v14, 16, v31
    v_and_b32 v15, s37, v31
    v_pk_add_f32 v[8:9], v[8:9], s[34:35] op_sel_hi:[1,0]
    v_pk_add_f32 v[10:11], v[10:11], s[34:35] op_sel_hi:[1,0]
    v_pk_add_f32 v[12:13], v[12:13], s[34:35] op_sel_hi:[1,0]
    v_pk_add_f32 v[14:15], v[14:15], s[34:35] op_sel_hi:[1,0]
    v_pk_add_f32 v[4:5], v[4:5], v[8:9]
    v_pk_fma_f32 v[6:7], v[8:9], v[8:9], v[6:7]
    v_pk_add_f32 v[4:5], v[4:5], v[10:11]
    v_pk_fma_f32 v[6:7], v[10:11], v[10:11], v[6:7]
    v_pk_add_f32 v[4:5], v[4:5], v[12:13]
    v_pk_fma_f32 v[6:7], v[12:13], v[12:13], v[6:7]
    v_pk_add_f32 v[4:5], v[4:5], v[14:15]
    v_pk_fma_f32 v[6:7], v[14:15], v[14:15], v[6:7]
    v_add_f32 v4, v4, v5
    v_add_f32 v6, v6, v7
    s_nop 1
    v_permlane32_swap_b32 v4, v6
    s_nop 1
    v_add_f32 v4, v4, v6
    s_nop 1
    v_add_f32_dpp v4, v4, v4 quad_perm:[1,0,3,2] row_mask:0xf bank_mask:0xf
    s_nop 1
    v_add_f32_dpp v4, v4, v4 quad_perm:[2,3,0,1] row_mask:0xf bank_mask:0xf
    s_nop 1
    v_add_f32_dpp v4, v4, v4 row_half_mirror row_mask:0xf bank_mask:0xf
    s_nop 1
    v_add_f32_dpp v4, v4, v4 row_mirror row_mask:0xf bank_mask:0xf
    s_nop 1
    v_add_f32_dpp v4, v4, v4 row_bcast:15 row_mask:0xa bank_mask:0xf
    v_writelane_b32 v4, s35, 0
    s_mov_b64 exec, s[38:39]
    ds_write_b32 v2, v4 offset:1552
    s_mov_b64 exec, -1
    s_set_gpr_idx_on s44, gpr_idx(DST)
    s_nop 0
    v_mov_b64 v[40:41], v[24:25]
    v_mov_b64 v[42:43], v[26:27]
    v_mov_b64 v[44:45], v[28:29]
    v_mov_b64 v[46:47], v[30:31]
    s_set_gpr_idx_off
    s_add_u32 s51, s51, 1
    s_add_u32 s44, s44, 8
    s_cmp_lt_u32 s44, 80
    s_cselect_b32 s44, s44, 0
L_sync1:
    ds_read_b32 v6, v0 offset:1552
    ds_read_b64 v[4:5], v32 offset:96
    s_waitcnt lgkmcnt(0)
    v_cmp_eq_u32 vcc, -1, v6
    v_readfirstlane_b32 s42, v4
    v_readfirstlane_b32 s43, v5
    s_cmp_eq_u64 vcc, 0
    s_cbranch_scc0 L_sync1
    s_cmp_eq_u32 s42, -1
    s_cbranch_scc1 L_sync1
    s_cmp_lt_u32 s51, 7
    s_cselect_b32 s3, 3, 1
    s_and_b32 s3, s3, s43
    s_and_b32 s33, s46, 1
    s_or_b32 s3, s3, s33
    s_and_b32 s43, s43, -4
    s_cmp_lt_u32 s51, 10
    s_cselect_b32 s3, s3, 0
    buffer_load_dwordx4 v[24:27], v1, s[12:15], s42 offen nt
    buffer_load_dwordx4 v[28:31], v1, s[12:15], s43 offen nt
    s_lshr_b32 s46, s46, 1
    s_cmp_eq_u32 s3, 0
    s_cbranch_scc1 L_store1
    buffer_store_dwordx4 v[36:39], v1, s[16:19], s47 offen
    buffer_store_dwordx4 v[36:39], v1, s[16:19], s47 offen
    s_branch L_next1
L_void1:
L_store1:
    ds_read_b128 v[4:7], v3 offset:0
    s_waitcnt lgkmcnt(0)
    v_readfirstlane_b32 s48, v4
    v_readfirstlane_b32 s49, v5
    v_cmp_eq_u32 vcc, -1, v7
    s_cmp_lt_i32 s48, 0
    s_cbranch_scc1 L_fin
    s_and_b32 s49, s49, -4
    s_cmp_eq_u64 vcc, 0
    s_cbranch_scc1 L_gres1
    s_sleep 1
    s_branch L_store1
L_gres1:
    s_set_gpr_idx_on s45, gpr_idx(SRC1)
    s_nop 0
    v_lshlrev_b32 v8, 16, v40
    v_and_b32 v9, s37, v40
    v_lshlrev_b32 v10, 16, v41
    v_and_b32 v11, s37, v41
    v_lshlrev_b32 v12, 16, v42
    v_and_b32 v13, s37, v42
    v_lshlrev_b32 v14, 16, v43
    v_and_b32 v15, s37, v43
    s_set_gpr_idx_off
    v_pk_fma_f32 v[8:9], v[8:9], v[6:7], v[6:7] op_sel:[0,0,1] op_sel_hi:[1,0,1]
    v_pk_fma_f32 v[10:11], v[10:11], v[6:7], v[6:7] op_sel:[0,0,1] op_sel_hi:[1,0,1]
    v_pk_fma_f32 v[12:13], v[12:13], v[6:7], v[6:7] op_sel:[0,0,1] op_sel_hi:[1,0,1]
    v_pk_fma_f32 v[14:15], v[14:15], v[6:7], v[6:7] op_sel:[0,0,1] op_sel_hi:[1,0,1]
    v_cvt_pk_bf16_f32 v36, v8, v9
    v_cvt_pk_bf16_f32 v37, v10, v11
    v_cvt_pk_bf16_f32 v38, v12, v13
    v_cvt_pk_bf16_f32 v39, v14, v15
    buffer_store_dwordx4 v[36:39], v1, s[16:19], s48 offen sc0 sc1
    s_set_gpr_idx_on s45, gpr_idx(SRC1)
    s_nop 0
    v_lshlrev_b32 v8, 16, v44
    v_and_b32 v9, s37, v44
    v_lshlrev_b32 v10, 16, v45
    v_and_b32 v11, s37, v45
    v_lshlrev_b32 v12, 16, v46
    v_and_b32 v13, s37, v46
    v_lshlrev_b32 v14, 16, v47
    v_and_b32 v15, s37, v47
    s_set_gpr_idx_off
    v_pk_fma_f32 v[8:9], v[8:9], v[6:7], v[6:7] op_sel:[0,0,1] op_sel_hi:[1,0,1]
    v_pk_fma_f32 v[10:11], v[10:11], v[6:7], v[6:7] op_sel:[0,0,1] op_sel_hi:[1,0,1]
    v_pk_fma_f32 v[12:13], v[12:13], v[6:7], v[6:7] op_sel:[0,0,1] op_sel_hi:[1,0,1]
    v_pk_fma_f32 v[14:15], v[14:15], v[6:7], v[6:7] op_sel:[0,0,1] op_sel_hi:[1,0,1]
    v_cvt_pk_bf16_f32 v8, v8, v9
    v_cvt_pk_bf16_f32 v9, v10, v11
    v_cvt_pk_bf16_f32 v10, v12, v13
    v_cvt_pk_bf16_f32 v11, v14, v15
    buffer_store_dwordx4 v[8:11], v1, s[16:19], s49 offen sc0 sc1
    s_add_u32 s45, s45, 8
    s_cmp_lt_u32 s45, 80
    s_cselect_b32 s45, s45, 0
    v_add_u32 v3, 32, v3
    s_sub_u32 s51, s51, 1
L_next1:
    v_add_u32 v2, 256, v2
    v_add_u32 v0, 256, v0
    v_add_u32 v32, 64, v32
    s_branch L_loop
L_fin:
    s_endpgm
L_tagw:
L_tagx0:
L_tagx:
    ds_read_b64 v[4:5], v9 offset:1408
    s_waitcnt lgkmcnt(0)
    v_readfirstlane_b32 s36, v4
    v_readfirstlane_b32 s3, v5
    s_sleep 1
    s_cmp_lg_u32 s3, 0
    s_cbranch_scc1 L_tagx
    s_sub_u32 s40, s24, 8
    s_mov_b32 s13, s36
    s_mov_b32 s15, s36
L_iter:
    s_lshl_b32 s3, s40, 5
    v_mov_b32 v5, s3
L_itkw:
    ds_read2_b32 v[16:17], v5 offset0:0 offset1:4
    s_waitcnt lgkmcnt(0)
    v_readfirstlane_b32 s42, v16
    v_readfirstlane_b32 s41, v17
    s_cmp_lg_u32 s42, -1
    s_cbranch_scc1 L_itkg
    s_sleep 1
    s_branch L_itkw
L_itkg:
    s_cmp_lt_i32 s42, 0
    s_cbranch_scc1 L_done
    s_cmp_eq_u32 s41, -1
    s_cbranch_scc1 L_itkw
    s_lshr_b32 s42, s41, 2
    s_and_b32 s42, s42, -4
    s_lshl_b32 s3, s40, 7
    v_lshl_add_u32 v4, v8, 1, s3
    s_lshr_b32 s39, s41, 3
    s_lshl_b32 s39, s39, 7
    s_add_u32 s39, s39, 1048576
    s_and_b32 s38, s41, 7
    s_lshl_b32 s38, s38, 4
    s_add_u32 s38, s38, s39
    s_add_u32 s18, s22, s38
    s_addc_u32 s19, s23, 0
    s_add_u32 s43, s39, 64
L_wpart:
    ds_read_b96 v[16:18], v4 offset:1424
    s_waitcnt lgkmcnt(0)
    v_max3_u32 v19, v16, v17, v18
    v_cmp_ne_u32 vcc, -1, v19
    s_nop 0
    s_mov_b32 s3, vcc_lo
    s_cmp_eq_u32 s3, 0xff
    s_cbranch_scc1 L_gpart
    s_sleep 1
    s_branch L_wpart
L_gpart:
    v_mul_f32 v19, 0x3a800000, v16
    v_add_f32 v18, v18, v19
    v_fma_f32 v17, -v19, v16, v17
    v_mov_b32 v16, v18
    s_nop 1
    v_add_f32_dpp v16, v16, v16 quad_perm:[1,0,3,2] row_mask:0xf bank_mask:0xf
    s_nop 1
    v_add_f32_dpp v16, v16, v16 quad_perm:[2,3,0,1] row_mask:0xf bank_mask:0xf
    s_nop 1
    v_add_f32_dpp v16, v16, v16 row_half_mirror row_mask:0xf bank_mask:0xf
    v_mul_f32 v16, 0x3e000000, v16
    v_sub_f32 v18, v18, v16
    v_mul_f32 v19, 0x44800000, v18
    v_fma_f32 v17, v19, v18, v17
    s_nop 1
    v_add_f32_dpp v17, v17, v17 quad_perm:[1,0,3,2] row_mask:0xf bank_mask:0xf
    s_nop 1
    v_add_f32_dpp v17, v17, v17 quad_perm:[2,3,0,1] row_mask:0xf bank_mask:0xf
    s_nop 1
    v_add_f32_dpp v17, v17, v17 row_half_mirror row_mask:0xf bank_mask:0xf
    v_readfirstlane_b32 s12, v16
    v_readfirstlane_b32 s14, v17
    s_mov_b32 s47, 0
    s_nop 2
    s_atomic_swap_x2 s[12:13], s[18:19], 0
    s_atomic_swap_x2 s[14:15], s[18:19], 8
    s_load_dword s44, s[6:7], s42
    s_load_dword s45, s[8:9], s42
L_later:
    ds_read_b32 v16, v4 offset:1552
    ds_read_b32 v17, v5 offset:32
    s_waitcnt lgkmcnt(0)
    v_cmp_eq_u32 vcc, -1, v16
    v_readfirstlane_b32 s3, v17
    s_cmp_eq_u32 vcc_lo, 0
    s_cbranch_scc1 L_polls
    s_cmp_eq_u32 s3, 0x80000000
    s_cbranch_scc1 L_polls
    s_sleep 1
    s_branch L_later
L_polls:
    s_load_dwordx16 s[52:67], s[22:23], s39 glc
    s_load_dwordx16 s[68:83], s[22:23], s43 glc
    s_add_u32 s47, s47, 1
    s_waitcnt lgkmcnt(0)
    s_and_b64 s[48:49], s[52:53], s[54:55]
    s_or_b64 s[50:51], s[52:53], s[54:55]
    s_and_b32 s49, s49, s57
    s_or_b32 s51, s51, s57
    s_and_b32 s49, s49, s59
    s_or_b32 s51, s51, s59
    s_and_b32 s49, s49, s61
    s_or_b32 s51, s51, s61
    s_and_b32 s49, s49, s63
    s_or_b32 s51, s51, s63
    s_and_b32 s49, s49, s65
    s_or_b32 s51, s51, s65
    s_and_b32 s49, s49, s67
    s_or_b32 s51, s51, s67
    s_and_b32 s49, s49, s69
    s_or_b32 s51, s51, s69
    s_and_b32 s49, s49, s71
    s_or_b32 s51, s51, s71
    s_and_b32 s49, s49, s73
    s_or_b32 s51, s51, s73
    s_and_b32 s49, s49, s75
    s_or_b32 s51, s51, s75
    s_and_b32 s49, s49, s77
    s_or_b32 s51, s51, s77
    s_and_b32 s49, s49, s79
    s_or_b32 s51, s51, s79
    s_and_b32 s49, s49, s81
    s_or_b32 s51, s51, s81
    s_and_b32 s49, s49, s83
    s_or_b32 s51, s51, s83
    s_xor_b32 s49, s49, s36
    s_xor_b32 s51, s51, s36
    s_or_b32 s49, s49, s51
    s_cbranch_scc0 L_polls_ok
    s_cmp_lt_u32 s47, 0x40000
    s_cbranch_scc1 L_polls
L_polls_ok:
    v_mov_b32 v16, s52
    v_mov_b32 v18, s54
    v_add_f32 v16, s56, v16
    v_add_f32 v18, s58, v18
    v_add_f32 v16, s60, v16
    v_add_f32 v18, s62, v18
    v_add_f32 v16, s64, v16
    v_add_f32 v18, s66, v18
    v_add_f32 v16, s68, v16
    v_add_f32 v18, s70, v18
    v_add_f32 v16, s72, v16
    v_add_f32 v18, s74, v18
    v_add_f32 v16, s76, v16
    v_add_f32 v18, s78, v18
    v_add_f32 v16, s80, v16
    v_add_f32 v18, s82, v18
    v_mul_f32 v16, 0x3e000000, v16
    v_cvt_pk_bf16_f32 v19, v16, v16
    v_mul_f32 v18, 0x39000000, v18
    v_lshlrev_b32 v16, 16, v19
    v_sub_f32 v20, s52, v16
    v_fmac_f32 v18, v20, v20
    v_sub_f32 v21, s56, v16
    v_fmac_f32 v18, v21, v21
    v_sub_f32 v20, s60, v16
    v_fmac_f32 v18, v20, v20
    v_sub_f32 v21, s64, v16
    v_fmac_f32 v18, v21, v21
    v_sub_f32 v20, s68, v16
    v_fmac_f32 v18, v20, v20
    v_sub_f32 v21, s72, v16
    v_fmac_f32 v18, v21, v21
    v_sub_f32 v20, s76, v16
    v_fmac_f32 v18, v20, v20
    v_sub_f32 v21, s80, v16
    v_fmac_f32 v18, v21, v21
    s_bitcmp1_b32 s41, 3
    s_cselect_b32 s3, 0, 16
    s_lshl_b32 s44, s44, s3
    s_lshl_b32 s45, s45, s3
    s_and_b32 s44, s44, 0xffff0000
    s_and_b32 s45, s45, 0xffff0000
    v_mul_f32 v18, 0x3e000000, v18
    v_cvt_pk_bf16_f32 v18, v18, v18
    v_lshlrev_b32 v18, 16, v18
    v_add_f32 v18, 0x3727c5ac, v18
    v_cvt_pk_bf16_f32 v18, v18, v18
    v_lshlrev_b32 v18, 16, v18
    v_sqrt_f32 v18, v18
    v_mov_b32 v21, s45
    v_cvt_pk_bf16_f32 v18, v18, v18
    v_lshlrev_b32 v18, 16, v18
    v_rcp_f32 v18, v18
    s_nop 0
    v_mul_f32 v20, s44, v18
    v_fma_f32 v21, -v16, v20, v21
    ds_write_b32 v5, v20 offset:8
    ds_write_b32 v5, v21 offset:12
    s_add_u32 s40, s40, 4
    s_branch L_iter
L_claimer:
    v_lshlrev_b32 v8, 3, v3
    s_mul_i32 s37, s36, 0x9e3779b1
    s_and_b32 s37, s37, 0xffff8000
    s_cmp_lg_u32 s2, 0
    s_cbranch_scc1 L_table
L_decide:
    s_mov_b32 s47, 0
L_ibw:
    s_load_dword s38, s[20:21], 0 glc
    s_load_dword s61, s[20:21], 64 glc
    s_load_dword s62, s[20:21], 128 glc
    s_load_dword s63, s[20:21], 192 glc
    ds_read_b32 v4, v9 offset:1680
    s_waitcnt lgkmcnt(0)
    s_or_b32 s38, s38, s61
    s_or_b32 s38, s38, s62
    s_or_b32 s38, s38, s63
    s_bfe_u32 s61, s38, 0xc0010
    s_and_b32 s62, s61, s38
    s_or_b32 s38, s38, s61
    s_or_b32 s39, s38, s32
    s_and_b32 s39, s39, 0xf000ffff
    s_cmp_eq_u32 s39, 0xf000ffff
    s_cbranch_scc1 L_ibg
    v_readfirstlane_b32 s48, v4
    s_not_b32 s48, s48
    s_cmp_lt_u32 s48, 1
    s_cbranch_scc1 L_ibw
    s_add_u32 s47, s47, 1
    s_cmp_ge_u32 s47, 0x40000
    s_cbranch_scc1 L_ibg
    s_and_b32 s39, s38, 0xf000f000
    s_cmp_eq_u32 s39, 0xf000f000
    s_cbranch_scc0 L_ibw
L_ibg:
    s_andn2_b32 s38, s38, s62
    s_lshr_b32 s46, s38, 16
    s_lshl_b32 s47, s46, 1
    s_xnor_b32 s47, s47, s46
    s_orn2_b32 s47, s47, s38
    s_lshl_b32 s3, s38, 1
    s_and_b32 s47, s47, s3
    s_and_b32 s47, s47, 0xaaa
    s_and_b32 s46, s46, 0x555
    s_or_b32 s45, s46, s47
    s_lshl_b32 s3, s41, 12
    s_or_b32 s45, s45, s3
    s_or_b32 s45, s45, s37
    s_mov_b64 exec, -1
    v_mov_b32 v16, s36
    v_mov_b32 v17, s45
    s_mov_b32 s3, 1708032
    v_lshl_add_u32 v4, v3, 7, s3
    global_store_dwordx2 v4, v[16:17], s[22:23] sc0 sc1
    s_mov_b64 exec, 0xff
    s_branch L_tbg
L_table:
    s_mov_b32 s3, 128
    v_lshl_add_u32 v4, v8, 1, s3
L_tbd:
    ds_read_b32 v16, v4 offset:1424
    s_waitcnt lgkmcnt(0)
    v_cmp_eq_u32 vcc, -1, v16
    s_sleep 2
    s_cmp_eq_u32 vcc_lo, 0
    s_cbranch_scc0 L_tbd
    s_and_b32 s42, s2, 63
    s_lshl_b32 s42, s42, 7
    s_add_u32 s42, s42, 1708032
    s_mov_b32 s47, 0
L_tbw:
    s_load_dwordx2 s[44:45], s[22:23], s42 glc
    s_add_u32 s47, s47, 1
    s_waitcnt lgkmcnt(0)
    s_xor_b32 s48, s44, s36
    s_xor_b32 s49, s45, s37
    s_lshr_b32 s49, s49, 15
    s_or_b32 s48, s48, s49
    s_cbranch_scc0 L_tbg
    s_sleep 2
    s_cmp_lt_u32 s47, 0x40000
    s_cbranch_scc1 L_tbw
L_tbg:
    s_and_b32 s38, s45, 0xfff
    s_lshl_b32 s38, s38, 6
    s_bfe_u32 s40, s45, 0x3000c
    s_add_u32 s40, s40, s2
    s_bfe_u32 s40, s40, 0x10002
    s_lshl_b32 s42, s40, 3
    s_add_u32 s42, s42, s27
    s_lshl_b32 s42, s42, 7
    s_add_u32 s42, s42, 1720320
    s_mov_b32 s43, 7
    s_mov_b32 s54, 0
    s_mov_b32 s55, 2
L_claim:
    s_sub_u32 s44, s43, 3
    s_lshl_b32 s44, s44, 7
    v_lshl_add_u32 v4, v8, 1, s44
L_cwait:
    ds_read_b32 v16, v4 offset:1424
    s_waitcnt lgkmcnt(0)
    v_cmp_eq_u32 vcc, -1, v16
    s_nop 0
    s_cmp_eq_u32 vcc_lo, 0
    s_cbranch_scc1 L_cgo
    s_sleep 1
    s_branch L_cwait
L_cgo:
    s_mov_b32 s47, 0x80000000
    s_cmp_lt_u32 s43, 36
    s_cbranch_scc0 L_cput
    s_mov_b32 s45, 1
    s_atomic_add s45, s[22:23], s42 glc
    s_waitcnt lgkmcnt(0)
    s_lshr_b32 s46, s45, 2
    s_lshl_b32 s46, s46, 3
    s_add_u32 s46, s46, s27
    s_add_u32 s46, s46, 224
    s_cmp_lt_u32 s46, 576
    s_cbranch_scc0 L_cput
    s_and_b32 s45, s45, 3
    s_lshr_b32 s48, s46, 6
    s_lshl_b32 s48, s48, 1
    s_lshr_b32 s48, s38, s48
    s_lshr_b32 s49, s46, 4
    s_xor_b32 s49, s49, s48
    s_xor_b32 s49, s49, s40
    s_and_b32 s49, s49, 1
    s_xor_b32 s50, s40, 1
    s_bitcmp1_b32 s48, 1
    s_cselect_b32 s50, s49, s50
    s_cselect_b32 s49, s49, s40
    s_lshl_b32 s51, s46, 2
    s_or_b32 s51, s51, s45
    s_lshl_b32 s51, s51, 15
    s_lshl_b32 s49, s49, 13
    s_or_b32 s47, s51, s49
    s_lshl_b32 s50, s50, 13
    s_or_b32 s50, s50, s51
    s_bfe_u32 s59, s48, 0x10001
    s_cmp_ge_u32 s46, 560
    s_cselect_b32 s56, 1, 0
    s_cmp_eq_u32 s54, 0
    s_cselect_b32 s57, 1, 0
    s_cselect_b32 s54, 3, s54
    s_sub_u32 s54, s54, 1
    s_andn2_b32 s57, s57, s59
    s_lshl_b32 s56, s56, 1
    s_or_b32 s56, s56, s57
    s_or_b32 s50, s50, s56
    s_or_b32 s48, s50, 0x4000
    s_lshl_b32 s49, s46, 1
    s_or_b32 s49, s49, s40
    s_lshl_b32 s49, s49, 2
    s_or_b32 s49, s49, s45
    v_mov_b32 v17, s48
    v_mov_b32 v18, s49
L_cput:
    v_mov_b32 v16, s47
    s_lshl_b32 s3, s43, 5
    v_mov_b32 v4, s3
    s_cmp_lt_i32 s47, 0
    s_cbranch_scc1 L_cend
    ds_write2_b32 v4, v17, v18 offset0:1 offset1:4
    ds_write_b32 v4, v16 offset:0
    s_add_u32 s43, s43, 1
    s_branch L_claim
L_cend:
    s_or_b32 s47, s47, s55
    v_mov_b32 v17, s47
    v_lshl_add_u32 v4, v8, 2, v4
    ds_write_b64 v4, v[16:17] offset:0
    s_cmp_lg_u32 s2, 0
    s_cbranch_scc1 L_done
    s_mov_b64 exec, -1
    s_mov_b32 s3, 1048580
    v_and_b32 v4, 7, v3
    v_lshl_add_u32 v4, v4, 4, s3
    v_lshrrev_b32 v5, 3, v3
    v_lshl_add_u32 v4, v5, 7, v4
    v_add_u32 v5, 1024, v4
    v_add_u32 v6, 2048, v4
    v_add_u32 v7, 3072, v4
    s_mov_b32 s47, 0
L_epw:
    global_load_dword v16, v4, s[22:23] sc0 sc1
    global_load_dword v17, v5, s[22:23] sc0 sc1
    global_load_dword v18, v6, s[22:23] sc0 sc1
    global_load_dword v19, v7, s[22:23] sc0 sc1
    s_add_u32 s47, s47, 1
    s_waitcnt vmcnt(0)
    v_xor_b32 v16, s36, v16
    v_xor_b32 v17, s36, v17
    v_xor_b32 v18, s36, v18
    v_xor_b32 v19, s36, v19
    v_or3_b32 v16, v16, v17, v18
    v_or_b32 v16, v16, v19
    v_cmp_ne_u32 vcc, 0, v16
    s_nop 0
    s_cmp_eq_u64 vcc, 0
    s_cbranch_scc1 L_epg
    s_cmp_lt_u32 s47, 0x40000
    s_cbranch_scc1 L_epw
L_epg:
    s_mov_b32 s3, 1703936
    s_atomic_swap s36, s[22:23], s3
L_done:
    s_endpgm
L_codeend:
.section .rodata,"a"
.p2align 6
.amdhsa_kernel standalone__instancenorm__prompt_kernel
  .amdhsa_next_free_vgpr 120
  .amdhsa_next_free_sgpr 88
  .amdhsa_accum_offset 120
  .amdhsa_group_segment_fixed_size 0
  .amdhsa_kernarg_size 48
  .amdhsa_user_sgpr_count 2
  .amdhsa_user_sgpr_kernarg_segment_ptr 1
  .amdhsa_system_sgpr_workgroup_id_x 1
  .amdhsa_float_denorm_mode_32 3
.end_amdhsa_kernel
```
